```python
import torch

def _softmax(x, axis=-1):
    return torch.softmax(x, dim=axis)

def _gelu(x):
    return torch.nn.functional.gelu(x, approximate='tanh')

def _silu(x):
    return torch.nn.functional.silu(x)

def _sigmoid(x):
    return torch.sigmoid(x)

def _layernorm(x, axis=-1, eps=1e-05):
    m = x.mean(dim=axis, keepdim=True)
    v = x.var(dim=axis, keepdim=True, unbiased=False)
    return (x - m) / torch.sqrt(v + eps)

def _scatter_add(tgt, idx, src, axis=0):
    return tgt.clone().index_add_(axis, idx, src)

def _segment_sum(src, seg, n):
    out = torch.zeros((n,) + src.shape[1:], dtype=src.dtype)
    return out.index_add_(0, seg, src)

def _pad(x, pw):
    flat = tuple((v for pair in reversed(pw) for v in pair))
    return torch.nn.functional.pad(x, flat)
kernel_name = 'standalone__autoregressive_conv_wavenet__speech'

def setup_inputs():

    _w = lambda a: (lambda t: t.to(torch.bfloat16) if t.is_floating_point() else t)(torch.as_tensor(a))
    B, T, D, K = (2, 4000, 256, 3)
    return {'x': _w((lambda *s: torch.randn(*s, dtype=torch.bfloat16) * 0.1)(B, T, D)), 'w': _w((lambda *s: torch.randn(*s, dtype=torch.bfloat16) * 0.1)(K, D, 2 * D)), 'w_o': _w((lambda *s: torch.randn(*s, dtype=torch.bfloat16) * 0.05)(D, D))}

def reference(x, w, w_o):
    B, T, D = x.shape
    K = w.shape[0]
    dil = 2
    pad = (K - 1) * dil
    xp = _pad(x, ((0, 0), (pad, 0), (0, 0)))
    h = torch.einsum('btc,cd->btd', xp[:, pad:pad + T, :], w[0])
    for i in range(1, K):
        off = pad - i * dil
        h = h + torch.einsum('btc,cd->btd', xp[:, off:off + T, :], w[i])
    f = h[..., :D].clone()
    g = h[..., D:].clone()
    z = torch.tanh(f) * _sigmoid(g)
    return z @ w_o
```

```asm
; @launch grid=(250,1,1) block=(512,1,1) lds=102400
.amdgcn_target "amdgcn-amd-amdhsa--gfx950"
.text
.globl standalone__autoregressive_conv_wavenet__speech_kernel
.p2align 8
.type standalone__autoregressive_conv_wavenet__speech_kernel,@function
standalone__autoregressive_conv_wavenet__speech_kernel:
    s_cmp_ge_u32 s2, 250
    s_cbranch_scc1 L_done
    s_load_dwordx4 s[4:7], s[0:1], 0
    s_load_dwordx4 s[8:11], s[0:1], 16
    s_cmp_ge_u32 s2, 125
    s_cselect_b32 s3, 125, 0
    s_sub_u32 s28, s2, s3
    s_lshl_b32 s28, s28, 5
    s_lshl_b32 s29, s2, 5
    v_lshrrev_b32 v1, 6, v0
    s_nop 0
    v_readfirstlane_b32 s30, v1
    v_and_b32 v2, 63, v0
    s_waitcnt lgkmcnt(0)
    s_mov_b32 s12, s4
    s_and_b32 s13, s5, 0xffff
    s_mov_b32 s14, 4096000
    s_mov_b32 s15, 0x00020000
    s_mov_b32 s16, s6
    s_and_b32 s17, s7, 0xffff
    s_mov_b32 s18, 786432
    s_mov_b32 s19, 0x00020000
    s_mov_b32 s20, s8
    s_and_b32 s21, s9, 0xffff
    s_mov_b32 s22, 131072
    s_mov_b32 s23, 0x00020000
    s_mov_b32 s24, s10
    s_and_b32 s25, s11, 0xffff
    s_mov_b32 s26, 4096000
    s_mov_b32 s27, 0x00020000
    v_add_u32 v3, 0, v0
    v_lshrrev_b32 v4, 5, v3
    v_and_b32 v5, 31, v3
    v_add_u32 v6, s28, v4
    v_cmp_gt_u32 vcc, 4, v6
    v_add_u32 v6, s29, v4
    v_subrev_u32 v6, 4, v6
    v_cndmask_b32 v6, v6, 0, vcc
    v_min_u32 v6, 7999, v6
    v_lshlrev_b32 v6, 9, v6
    v_lshl_add_u32 v6, v5, 4, v6
    buffer_load_dwordx4 v[8:11], v6, s[12:15], 0 offen
    v_add_u32 v3, 512, v0
    v_lshrrev_b32 v4, 5, v3
    v_and_b32 v5, 31, v3
    v_add_u32 v6, s28, v4
    v_cmp_gt_u32 vcc, 4, v6
    v_add_u32 v6, s29, v4
    v_subrev_u32 v6, 4, v6
    v_cndmask_b32 v6, v6, 0, vcc
    v_min_u32 v6, 7999, v6
    v_lshlrev_b32 v6, 9, v6
    v_lshl_add_u32 v6, v5, 4, v6
    buffer_load_dwordx4 v[12:15], v6, s[12:15], 0 offen
    v_add_u32 v3, 1024, v0
    v_lshrrev_b32 v4, 5, v3
    v_and_b32 v5, 31, v3
    v_add_u32 v6, s28, v4
    v_cmp_gt_u32 vcc, 4, v6
    v_add_u32 v6, s29, v4
    v_subrev_u32 v6, 4, v6
    v_cndmask_b32 v6, v6, 0, vcc
    v_min_u32 v6, 7999, v6
    v_lshlrev_b32 v6, 9, v6
    v_lshl_add_u32 v6, v5, 4, v6
    buffer_load_dwordx4 v[16:19], v6, s[12:15], 0 offen
    v_lshrrev_b32 v3, 2, v2
    v_and_b32 v4, 3, v2
    v_lshlrev_b32 v4, 4, v4
    v_lshl_add_u32 v40, v3, 10, v4
    v_lshl_add_u32 v41, v3, 9, v4
    s_mul_i32 s31, s30, 8192
    s_add_u32 s31, s31, 36864
    s_lshl_b32 s32, s30, 6
    s_mul_hi_u32 s40, s2, 357913942
    s_mul_i32 s40, s40, 12
    s_sub_u32 s40, s2, s40
    s_lshl_b32 s40, s40, 6
    s_lshl_b32 s36, s40, 10
    s_add_u32 s36, s36, s32
    v_lshrrev_b32 v3, 5, v2
    v_lshlrev_b32 v42, 9, v3
    v_and_b32 v3, 15, v2
    v_lshrrev_b32 v3, 2, v3
    v_lshl_add_u32 v42, v3, 6, v42
    v_lshrrev_b32 v3, 4, v2
    v_and_b32 v3, 1, v3
    v_lshl_add_u32 v42, v3, 5, v42
    v_and_b32 v3, 3, v2
    v_lshl_add_u32 v42, v3, 3, v42
    v_add_u32 v42, s31, v42
    v_and_b32 v3, 31, v2
    v_mul_u32_u24 v43, 528, v3
    v_lshrrev_b32 v3, 5, v2
    v_lshl_add_u32 v43, v3, 4, v43
    s_add_u32 s41, s40, 64
    s_cmp_eq_u32 s41, 768
    s_cselect_b32 s41, 0, s41
    s_lshl_b32 s39, s41, 10
    s_add_u32 s39, s39, s32
    s_lshr_b32 s42, s40, 8
    s_mul_i32 s42, s42, 1056
    s_and_b32 s43, s40, 255
    s_lshl_b32 s43, s43, 1
    s_sub_u32 s43, s43, s42
    s_add_u32 s43, s43, 2112
    v_add_u32 v44, s43, v43
    s_add_u32 s33, s36, 0
    s_add_u32 m0, s31, 0
    s_nop 0
    buffer_load_dwordx4 v40, s[16:19], s33 offen lds
    s_add_u32 s33, s36, 512
    s_add_u32 m0, s31, 1024
    s_nop 0
    buffer_load_dwordx4 v40, s[16:19], s33 offen lds
    s_add_u32 s33, s36, 16384
    s_add_u32 m0, s31, 2048
    s_nop 0
    buffer_load_dwordx4 v40, s[16:19], s33 offen lds
    s_add_u32 s33, s36, 16896
    s_add_u32 m0, s31, 3072
    s_nop 0
    buffer_load_dwordx4 v40, s[16:19], s33 offen lds
    s_add_u32 s33, s36, 32768
    s_add_u32 m0, s31, 4096
    s_nop 0
    buffer_load_dwordx4 v40, s[16:19], s33 offen lds
    s_add_u32 s33, s36, 33280
    s_add_u32 m0, s31, 5120
    s_nop 0
    buffer_load_dwordx4 v40, s[16:19], s33 offen lds
    s_waitcnt vmcnt(6)
    v_add_u32 v3, 0, v0
    v_lshrrev_b32 v4, 5, v3
    v_and_b32 v5, 31, v3
    v_add_u32 v6, s28, v4
    v_cmp_gt_u32 vcc, 4, v6
    v_cndmask_b32 v8, v8, 0, vcc
    v_cndmask_b32 v9, v9, 0, vcc
    v_cndmask_b32 v10, v10, 0, vcc
    v_cndmask_b32 v11, v11, 0, vcc
    v_mul_u32_u24 v6, 528, v4
    v_lshl_add_u32 v6, v5, 4, v6
    ds_write_b128 v6, v[8:11] offset:0
    v_add_u32 v3, 512, v0
    v_lshrrev_b32 v4, 5, v3
    v_and_b32 v5, 31, v3
    v_add_u32 v6, s28, v4
    v_cmp_gt_u32 vcc, 4, v6
    v_cndmask_b32 v12, v12, 0, vcc
    v_cndmask_b32 v13, v13, 0, vcc
    v_cndmask_b32 v14, v14, 0, vcc
    v_cndmask_b32 v15, v15, 0, vcc
    v_mul_u32_u24 v6, 528, v4
    v_lshl_add_u32 v6, v5, 4, v6
    ds_write_b128 v6, v[12:15] offset:0
    v_add_u32 v3, 1024, v0
    v_lshrrev_b32 v4, 5, v3
    v_and_b32 v5, 31, v3
    v_add_u32 v6, s28, v4
    v_cmp_gt_u32 vcc, 4, v6
    v_cndmask_b32 v16, v16, 0, vcc
    v_cndmask_b32 v17, v17, 0, vcc
    v_cndmask_b32 v18, v18, 0, vcc
    v_cndmask_b32 v19, v19, 0, vcc
    v_mul_u32_u24 v6, 528, v4
    v_lshl_add_u32 v6, v5, 4, v6
    v_cmp_gt_u32 vcc, 128, v0
    s_and_saveexec_b64 s[34:35], vcc
    ds_write_b128 v6, v[16:19] offset:0
    s_mov_b64 exec, s[34:35]
    s_waitcnt lgkmcnt(0)
    s_barrier
    v_mov_b32 v64, 0
    v_mov_b32 v65, 0
    v_mov_b32 v66, 0
    v_mov_b32 v67, 0
    v_mov_b32 v68, 0
    v_mov_b32 v69, 0
    v_mov_b32 v70, 0
    v_mov_b32 v71, 0
    v_mov_b32 v72, 0
    v_mov_b32 v73, 0
    v_mov_b32 v74, 0
    v_mov_b32 v75, 0
    v_mov_b32 v76, 0
    v_mov_b32 v77, 0
    v_mov_b32 v78, 0
    v_mov_b32 v79, 0
    v_mov_b32 v80, 0
    v_mov_b32 v81, 0
    v_mov_b32 v82, 0
    v_mov_b32 v83, 0
    v_mov_b32 v84, 0
    v_mov_b32 v85, 0
    v_mov_b32 v86, 0
    v_mov_b32 v87, 0
    v_mov_b32 v88, 0
    v_mov_b32 v89, 0
    v_mov_b32 v90, 0
    v_mov_b32 v91, 0
    v_mov_b32 v92, 0
    v_mov_b32 v93, 0
    v_mov_b32 v94, 0
    v_mov_b32 v95, 0
    s_mov_b32 s37, 0
    s_waitcnt vmcnt(4)
    ds_read_b64_tr_b16 v[96:97], v42 offset:0
    ds_read_b64_tr_b16 v[98:99], v42 offset:256
    ds_read_b64_tr_b16 v[100:101], v42 offset:1024
    ds_read_b64_tr_b16 v[102:103], v42 offset:1280
    ds_read_b128 v[104:107], v44 offset:0
    s_waitcnt lgkmcnt(0)
    s_add_u32 s33, s36, 49152
    s_add_u32 m0, s31, 6144
    s_nop 0
    buffer_load_dwordx4 v40, s[16:19], s33 offen lds
    s_add_u32 s33, s36, 49664
    s_add_u32 m0, s31, 7168
    s_nop 0
    buffer_load_dwordx4 v40, s[16:19], s33 offen lds
L_loop:
    s_waitcnt vmcnt(4)
    ds_read_b64_tr_b16 v[108:109], v42 offset:2048
    ds_read_b64_tr_b16 v[110:111], v42 offset:2304
    ds_read_b64_tr_b16 v[112:113], v42 offset:3072
    ds_read_b64_tr_b16 v[114:115], v42 offset:3328
    ds_read_b128 v[116:119], v44 offset:32
    v_mfma_f32_32x32x16_bf16 v[64:79], v[96:99], v[104:107], v[64:79]
    v_mfma_f32_32x32x16_bf16 v[80:95], v[100:103], v[104:107], v[80:95]
    s_waitcnt lgkmcnt(0)
    s_add_u32 s33, s39, 0
    s_add_u32 m0, s31, 0
    s_nop 0
    buffer_load_dwordx4 v40, s[16:19], s33 offen lds
    s_add_u32 s33, s39, 512
    s_add_u32 m0, s31, 1024
    s_nop 0
    buffer_load_dwordx4 v40, s[16:19], s33 offen lds
    s_waitcnt vmcnt(4)
    ds_read_b64_tr_b16 v[96:97], v42 offset:4096
    ds_read_b64_tr_b16 v[98:99], v42 offset:4352
    ds_read_b64_tr_b16 v[100:101], v42 offset:5120
    ds_read_b64_tr_b16 v[102:103], v42 offset:5376
    ds_read_b128 v[104:107], v44 offset:64
    v_mfma_f32_32x32x16_bf16 v[64:79], v[108:111], v[116:119], v[64:79]
    v_mfma_f32_32x32x16_bf16 v[80:95], v[112:115], v[116:119], v[80:95]
    s_waitcnt lgkmcnt(0)
    s_add_u32 s33, s39, 16384
    s_add_u32 m0, s31, 2048
    s_nop 0
    buffer_load_dwordx4 v40, s[16:19], s33 offen lds
    s_add_u32 s33, s39, 16896
    s_add_u32 m0, s31, 3072
    s_nop 0
    buffer_load_dwordx4 v40, s[16:19], s33 offen lds
    s_waitcnt vmcnt(4)
    ds_read_b64_tr_b16 v[108:109], v42 offset:6144
    ds_read_b64_tr_b16 v[110:111], v42 offset:6400
    ds_read_b64_tr_b16 v[112:113], v42 offset:7168
    ds_read_b64_tr_b16 v[114:115], v42 offset:7424
    ds_read_b128 v[116:119], v44 offset:96
    v_mfma_f32_32x32x16_bf16 v[64:79], v[96:99], v[104:107], v[64:79]
    v_mfma_f32_32x32x16_bf16 v[80:95], v[100:103], v[104:107], v[80:95]
    s_waitcnt lgkmcnt(0)
    s_add_u32 s33, s39, 32768
    s_add_u32 m0, s31, 4096
    s_nop 0
    buffer_load_dwordx4 v40, s[16:19], s33 offen lds
    s_add_u32 s33, s39, 33280
    s_add_u32 m0, s31, 5120
    s_nop 0
    buffer_load_dwordx4 v40, s[16:19], s33 offen lds
    s_waitcnt vmcnt(4)
    s_mov_b32 s40, s41
    s_mov_b32 s36, s39
    s_add_u32 s41, s40, 64
    s_cmp_eq_u32 s41, 768
    s_cselect_b32 s41, 0, s41
    s_lshl_b32 s39, s41, 10
    s_add_u32 s39, s39, s32
    s_lshr_b32 s42, s40, 8
    s_mul_i32 s42, s42, 1056
    s_and_b32 s43, s40, 255
    s_lshl_b32 s43, s43, 1
    s_sub_u32 s43, s43, s42
    s_add_u32 s43, s43, 2112
    v_add_u32 v44, s43, v43
    ds_read_b64_tr_b16 v[96:97], v42 offset:0
    ds_read_b64_tr_b16 v[98:99], v42 offset:256
    ds_read_b64_tr_b16 v[100:101], v42 offset:1024
    ds_read_b64_tr_b16 v[102:103], v42 offset:1280
    ds_read_b128 v[104:107], v44 offset:0
    v_mfma_f32_32x32x16_bf16 v[64:79], v[108:111], v[116:119], v[64:79]
    v_mfma_f32_32x32x16_bf16 v[80:95], v[112:115], v[116:119], v[80:95]
    s_waitcnt lgkmcnt(0)
    s_add_u32 s33, s36, 49152
    s_add_u32 m0, s31, 6144
    s_nop 0
    buffer_load_dwordx4 v40, s[16:19], s33 offen lds
    s_add_u32 s33, s36, 49664
    s_add_u32 m0, s31, 7168
    s_nop 0
    buffer_load_dwordx4 v40, s[16:19], s33 offen lds
    s_add_u32 s37, s37, 1
    s_cmp_lt_u32 s37, 11
    s_cbranch_scc1 L_loop
    s_waitcnt vmcnt(4)
    ds_read_b64_tr_b16 v[108:109], v42 offset:2048
    ds_read_b64_tr_b16 v[110:111], v42 offset:2304
    ds_read_b64_tr_b16 v[112:113], v42 offset:3072
    ds_read_b64_tr_b16 v[114:115], v42 offset:3328
    ds_read_b128 v[116:119], v44 offset:32
    v_mfma_f32_32x32x16_bf16 v[64:79], v[96:99], v[104:107], v[64:79]
    v_mfma_f32_32x32x16_bf16 v[80:95], v[100:103], v[104:107], v[80:95]
    s_waitcnt lgkmcnt(0)
    s_add_u32 s33, s32, 0
    s_add_u32 m0, s31, 0
    s_nop 0
    buffer_load_dwordx4 v41, s[20:23], s33 offen lds
    s_add_u32 s33, s32, 8192
    s_add_u32 m0, s31, 1024
    s_nop 0
    buffer_load_dwordx4 v41, s[20:23], s33 offen lds
    s_waitcnt vmcnt(4)
    ds_read_b64_tr_b16 v[96:97], v42 offset:4096
    ds_read_b64_tr_b16 v[98:99], v42 offset:4352
    ds_read_b64_tr_b16 v[100:101], v42 offset:5120
    ds_read_b64_tr_b16 v[102:103], v42 offset:5376
    ds_read_b128 v[104:107], v44 offset:64
    v_mfma_f32_32x32x16_bf16 v[64:79], v[108:111], v[116:119], v[64:79]
    v_mfma_f32_32x32x16_bf16 v[80:95], v[112:115], v[116:119], v[80:95]
    s_waitcnt lgkmcnt(0)
    s_add_u32 s33, s32, 16384
    s_add_u32 m0, s31, 2048
    s_nop 0
    buffer_load_dwordx4 v41, s[20:23], s33 offen lds
    s_add_u32 s33, s32, 24576
    s_add_u32 m0, s31, 3072
    s_nop 0
    buffer_load_dwordx4 v41, s[20:23], s33 offen lds
    s_waitcnt vmcnt(4)
    ds_read_b64_tr_b16 v[108:109], v42 offset:6144
    ds_read_b64_tr_b16 v[110:111], v42 offset:6400
    ds_read_b64_tr_b16 v[112:113], v42 offset:7168
    ds_read_b64_tr_b16 v[114:115], v42 offset:7424
    ds_read_b128 v[116:119], v44 offset:96
    v_mfma_f32_32x32x16_bf16 v[64:79], v[96:99], v[104:107], v[64:79]
    v_mfma_f32_32x32x16_bf16 v[80:95], v[100:103], v[104:107], v[80:95]
    s_waitcnt lgkmcnt(0)
    s_add_u32 s33, s32, 32768
    s_add_u32 m0, s31, 4096
    s_nop 0
    buffer_load_dwordx4 v41, s[20:23], s33 offen lds
    s_add_u32 s33, s32, 40960
    s_add_u32 m0, s31, 5120
    s_nop 0
    buffer_load_dwordx4 v41, s[20:23], s33 offen lds
    v_mfma_f32_32x32x16_bf16 v[64:79], v[108:111], v[116:119], v[64:79]
    v_mfma_f32_32x32x16_bf16 v[80:95], v[112:115], v[116:119], v[80:95]
    s_add_u32 s33, s32, 49152
    s_add_u32 m0, s31, 6144
    s_nop 0
    buffer_load_dwordx4 v41, s[20:23], s33 offen lds
    s_add_u32 s33, s32, 57344
    s_add_u32 m0, s31, 7168
    s_nop 0
    buffer_load_dwordx4 v41, s[20:23], s33 offen lds
    s_nop 7
    s_nop 7
    v_mov_b32 v3, 0x4038aa3b
    v_mov_b32 v4, 0xbfb8aa3b
    v_lshrrev_b32 v5, 5, v2
    v_and_b32 v6, 31, v2
    v_mul_u32_u24 v6, 528, v6
    v_lshl_add_u32 v6, v5, 3, v6
    v_add_u32 v6, s32, v6
    v_mul_f32 v8, v3, v64
    v_mul_f32 v12, v4, v80
    v_mul_f32 v9, v3, v65
    v_mul_f32 v13, v4, v81
    v_mul_f32 v10, v3, v66
    v_mul_f32 v14, v4, v82
    v_mul_f32 v11, v3, v67
    v_mul_f32 v15, v4, v83
    v_exp_f32 v8, v8
    v_exp_f32 v9, v9
    v_exp_f32 v10, v10
    v_exp_f32 v11, v11
    v_exp_f32 v12, v12
    v_exp_f32 v13, v13
    v_exp_f32 v14, v14
    v_exp_f32 v15, v15
    v_add_f32 v8, 1.0, v8
    v_add_f32 v9, 1.0, v9
    v_add_f32 v10, 1.0, v10
    v_add_f32 v11, 1.0, v11
    v_add_f32 v12, 1.0, v12
    v_add_f32 v13, 1.0, v13
    v_add_f32 v14, 1.0, v14
    v_add_f32 v15, 1.0, v15
    v_rcp_f32 v8, v8
    v_rcp_f32 v9, v9
    v_rcp_f32 v10, v10
    v_rcp_f32 v11, v11
    v_rcp_f32 v12, v12
    v_rcp_f32 v13, v13
    v_rcp_f32 v14, v14
    v_rcp_f32 v15, v15
    v_fma_f32 v8, v8, -2.0, 1.0
    v_fma_f32 v9, v9, -2.0, 1.0
    v_fma_f32 v10, v10, -2.0, 1.0
    v_fma_f32 v11, v11, -2.0, 1.0
    v_mul_f32 v8, v8, v12
    v_mul_f32 v9, v9, v13
    v_mul_f32 v10, v10, v14
    v_mul_f32 v11, v11, v15
    v_cvt_pk_bf16_f32 v16, v8, v9
    v_cvt_pk_bf16_f32 v17, v10, v11
    ds_write_b64 v6, v[16:17] offset:19008
    v_mul_f32 v8, v3, v68
    v_mul_f32 v12, v4, v84
    v_mul_f32 v9, v3, v69
    v_mul_f32 v13, v4, v85
    v_mul_f32 v10, v3, v70
    v_mul_f32 v14, v4, v86
    v_mul_f32 v11, v3, v71
    v_mul_f32 v15, v4, v87
    v_exp_f32 v8, v8
    v_exp_f32 v9, v9
    v_exp_f32 v10, v10
    v_exp_f32 v11, v11
    v_exp_f32 v12, v12
    v_exp_f32 v13, v13
    v_exp_f32 v14, v14
    v_exp_f32 v15, v15
    v_add_f32 v8, 1.0, v8
    v_add_f32 v9, 1.0, v9
    v_add_f32 v10, 1.0, v10
    v_add_f32 v11, 1.0, v11
    v_add_f32 v12, 1.0, v12
    v_add_f32 v13, 1.0, v13
    v_add_f32 v14, 1.0, v14
    v_add_f32 v15, 1.0, v15
    v_rcp_f32 v8, v8
    v_rcp_f32 v9, v9
    v_rcp_f32 v10, v10
    v_rcp_f32 v11, v11
    v_rcp_f32 v12, v12
    v_rcp_f32 v13, v13
    v_rcp_f32 v14, v14
    v_rcp_f32 v15, v15
    v_fma_f32 v8, v8, -2.0, 1.0
    v_fma_f32 v9, v9, -2.0, 1.0
    v_fma_f32 v10, v10, -2.0, 1.0
    v_fma_f32 v11, v11, -2.0, 1.0
    v_mul_f32 v8, v8, v12
    v_mul_f32 v9, v9, v13
    v_mul_f32 v10, v10, v14
    v_mul_f32 v11, v11, v15
    v_cvt_pk_bf16_f32 v16, v8, v9
    v_cvt_pk_bf16_f32 v17, v10, v11
    ds_write_b64 v6, v[16:17] offset:19024
    v_mul_f32 v8, v3, v72
    v_mul_f32 v12, v4, v88
    v_mul_f32 v9, v3, v73
    v_mul_f32 v13, v4, v89
    v_mul_f32 v10, v3, v74
    v_mul_f32 v14, v4, v90
    v_mul_f32 v11, v3, v75
    v_mul_f32 v15, v4, v91
    v_exp_f32 v8, v8
    v_exp_f32 v9, v9
    v_exp_f32 v10, v10
    v_exp_f32 v11, v11
    v_exp_f32 v12, v12
    v_exp_f32 v13, v13
    v_exp_f32 v14, v14
    v_exp_f32 v15, v15
    v_add_f32 v8, 1.0, v8
    v_add_f32 v9, 1.0, v9
    v_add_f32 v10, 1.0, v10
    v_add_f32 v11, 1.0, v11
    v_add_f32 v12, 1.0, v12
    v_add_f32 v13, 1.0, v13
    v_add_f32 v14, 1.0, v14
    v_add_f32 v15, 1.0, v15
    v_rcp_f32 v8, v8
    v_rcp_f32 v9, v9
    v_rcp_f32 v10, v10
    v_rcp_f32 v11, v11
    v_rcp_f32 v12, v12
    v_rcp_f32 v13, v13
    v_rcp_f32 v14, v14
    v_rcp_f32 v15, v15
    v_fma_f32 v8, v8, -2.0, 1.0
    v_fma_f32 v9, v9, -2.0, 1.0
    v_fma_f32 v10, v10, -2.0, 1.0
    v_fma_f32 v11, v11, -2.0, 1.0
    v_mul_f32 v8, v8, v12
    v_mul_f32 v9, v9, v13
    v_mul_f32 v10, v10, v14
    v_mul_f32 v11, v11, v15
    v_cvt_pk_bf16_f32 v16, v8, v9
    v_cvt_pk_bf16_f32 v17, v10, v11
    ds_write_b64 v6, v[16:17] offset:19040
    v_mul_f32 v8, v3, v76
    v_mul_f32 v12, v4, v92
    v_mul_f32 v9, v3, v77
    v_mul_f32 v13, v4, v93
    v_mul_f32 v10, v3, v78
    v_mul_f32 v14, v4, v94
    v_mul_f32 v11, v3, v79
    v_mul_f32 v15, v4, v95
    v_exp_f32 v8, v8
    v_exp_f32 v9, v9
    v_exp_f32 v10, v10
    v_exp_f32 v11, v11
    v_exp_f32 v12, v12
    v_exp_f32 v13, v13
    v_exp_f32 v14, v14
    v_exp_f32 v15, v15
    v_add_f32 v8, 1.0, v8
    v_add_f32 v9, 1.0, v9
    v_add_f32 v10, 1.0, v10
    v_add_f32 v11, 1.0, v11
    v_add_f32 v12, 1.0, v12
    v_add_f32 v13, 1.0, v13
    v_add_f32 v14, 1.0, v14
    v_add_f32 v15, 1.0, v15
    v_rcp_f32 v8, v8
    v_rcp_f32 v9, v9
    v_rcp_f32 v10, v10
    v_rcp_f32 v11, v11
    v_rcp_f32 v12, v12
    v_rcp_f32 v13, v13
    v_rcp_f32 v14, v14
    v_rcp_f32 v15, v15
    v_fma_f32 v8, v8, -2.0, 1.0
    v_fma_f32 v9, v9, -2.0, 1.0
    v_fma_f32 v10, v10, -2.0, 1.0
    v_fma_f32 v11, v11, -2.0, 1.0
    v_mul_f32 v8, v8, v12
    v_mul_f32 v9, v9, v13
    v_mul_f32 v10, v10, v14
    v_mul_f32 v11, v11, v15
    v_cvt_pk_bf16_f32 v16, v8, v9
    v_cvt_pk_bf16_f32 v17, v10, v11
    ds_write_b64 v6, v[16:17] offset:19056
    s_waitcnt lgkmcnt(0)
    s_barrier
    v_mov_b32 v64, 0
    v_mov_b32 v65, 0
    v_mov_b32 v66, 0
    v_mov_b32 v67, 0
    v_mov_b32 v68, 0
    v_mov_b32 v69, 0
    v_mov_b32 v70, 0
    v_mov_b32 v71, 0
    v_mov_b32 v72, 0
    v_mov_b32 v73, 0
    v_mov_b32 v74, 0
    v_mov_b32 v75, 0
    v_mov_b32 v76, 0
    v_mov_b32 v77, 0
    v_mov_b32 v78, 0
    v_mov_b32 v79, 0
    v_add_u32 v43, 19008, v43
    s_waitcnt vmcnt(7)
    ds_read_b64_tr_b16 v[96:97], v42 offset:0
    ds_read_b64_tr_b16 v[98:99], v42 offset:256
    ds_read_b128 v[104:107], v43 offset:0
    s_waitcnt lgkmcnt(0)
    s_add_u32 s33, s32, 65536
    s_add_u32 m0, s31, 0
    s_nop 0
    buffer_load_dwordx4 v41, s[20:23], s33 offen lds
    s_waitcnt vmcnt(7)
    ds_read_b64_tr_b16 v[108:109], v42 offset:1024
    ds_read_b64_tr_b16 v[110:111], v42 offset:1280
    ds_read_b128 v[116:119], v43 offset:32
    v_mfma_f32_32x32x16_bf16 v[64:79], v[96:99], v[104:107], v[64:79]
    s_waitcnt lgkmcnt(0)
    s_add_u32 s33, s32, 73728
    s_add_u32 m0, s31, 1024
    s_nop 0
    buffer_load_dwordx4 v41, s[20:23], s33 offen lds
    s_waitcnt vmcnt(7)
    ds_read_b64_tr_b16 v[96:97], v42 offset:2048
    ds_read_b64_tr_b16 v[98:99], v42 offset:2304
    ds_read_b128 v[104:107], v43 offset:64
    v_mfma_f32_32x32x16_bf16 v[64:79], v[108:111], v[116:119], v[64:79]
    s_waitcnt lgkmcnt(0)
    s_add_u32 s33, s32, 81920
    s_add_u32 m0, s31, 2048
    s_nop 0
    buffer_load_dwordx4 v41, s[20:23], s33 offen lds
    s_waitcnt vmcnt(7)
    ds_read_b64_tr_b16 v[108:109], v42 offset:3072
    ds_read_b64_tr_b16 v[110:111], v42 offset:3328
    ds_read_b128 v[116:119], v43 offset:96
    v_mfma_f32_32x32x16_bf16 v[64:79], v[96:99], v[104:107], v[64:79]
    s_waitcnt lgkmcnt(0)
    s_add_u32 s33, s32, 90112
    s_add_u32 m0, s31, 3072
    s_nop 0
    buffer_load_dwordx4 v41, s[20:23], s33 offen lds
    s_waitcnt vmcnt(7)
    ds_read_b64_tr_b16 v[96:97], v42 offset:4096
    ds_read_b64_tr_b16 v[98:99], v42 offset:4352
    ds_read_b128 v[104:107], v43 offset:128
    v_mfma_f32_32x32x16_bf16 v[64:79], v[108:111], v[116:119], v[64:79]
    s_waitcnt lgkmcnt(0)
    s_add_u32 s33, s32, 98304
    s_add_u32 m0, s31, 4096
    s_nop 0
    buffer_load_dwordx4 v41, s[20:23], s33 offen lds
    s_waitcnt vmcnt(7)
    ds_read_b64_tr_b16 v[108:109], v42 offset:5120
    ds_read_b64_tr_b16 v[110:111], v42 offset:5376
    ds_read_b128 v[116:119], v43 offset:160
    v_mfma_f32_32x32x16_bf16 v[64:79], v[96:99], v[104:107], v[64:79]
    s_waitcnt lgkmcnt(0)
    s_add_u32 s33, s32, 106496
    s_add_u32 m0, s31, 5120
    s_nop 0
    buffer_load_dwordx4 v41, s[20:23], s33 offen lds
    s_waitcnt vmcnt(7)
    ds_read_b64_tr_b16 v[96:97], v42 offset:6144
    ds_read_b64_tr_b16 v[98:99], v42 offset:6400
    ds_read_b128 v[104:107], v43 offset:192
    v_mfma_f32_32x32x16_bf16 v[64:79], v[108:111], v[116:119], v[64:79]
    s_waitcnt lgkmcnt(0)
    s_add_u32 s33, s32, 114688
    s_add_u32 m0, s31, 6144
    s_nop 0
    buffer_load_dwordx4 v41, s[20:23], s33 offen lds
    s_waitcnt vmcnt(7)
    ds_read_b64_tr_b16 v[108:109], v42 offset:7168
    ds_read_b64_tr_b16 v[110:111], v42 offset:7424
    ds_read_b128 v[116:119], v43 offset:224
    v_mfma_f32_32x32x16_bf16 v[64:79], v[96:99], v[104:107], v[64:79]
    s_waitcnt lgkmcnt(0)
    s_add_u32 s33, s32, 122880
    s_add_u32 m0, s31, 7168
    s_nop 0
    buffer_load_dwordx4 v41, s[20:23], s33 offen lds
    s_waitcnt vmcnt(7)
    ds_read_b64_tr_b16 v[96:97], v42 offset:0
    ds_read_b64_tr_b16 v[98:99], v42 offset:256
    ds_read_b128 v[104:107], v43 offset:256
    v_mfma_f32_32x32x16_bf16 v[64:79], v[108:111], v[116:119], v[64:79]
    s_waitcnt lgkmcnt(0)
    s_waitcnt vmcnt(6)
    ds_read_b64_tr_b16 v[108:109], v42 offset:1024
    ds_read_b64_tr_b16 v[110:111], v42 offset:1280
    ds_read_b128 v[116:119], v43 offset:288
    v_mfma_f32_32x32x16_bf16 v[64:79], v[96:99], v[104:107], v[64:79]
    s_waitcnt lgkmcnt(0)
    s_waitcnt vmcnt(5)
    ds_read_b64_tr_b16 v[96:97], v42 offset:2048
    ds_read_b64_tr_b16 v[98:99], v42 offset:2304
    ds_read_b128 v[104:107], v43 offset:320
    v_mfma_f32_32x32x16_bf16 v[64:79], v[108:111], v[116:119], v[64:79]
    s_waitcnt lgkmcnt(0)
    s_waitcnt vmcnt(4)
    ds_read_b64_tr_b16 v[108:109], v42 offset:3072
    ds_read_b64_tr_b16 v[110:111], v42 offset:3328
    ds_read_b128 v[116:119], v43 offset:352
    v_mfma_f32_32x32x16_bf16 v[64:79], v[96:99], v[104:107], v[64:79]
    s_waitcnt lgkmcnt(0)
    s_waitcnt vmcnt(3)
    ds_read_b64_tr_b16 v[96:97], v42 offset:4096
    ds_read_b64_tr_b16 v[98:99], v42 offset:4352
    ds_read_b128 v[104:107], v43 offset:384
    v_mfma_f32_32x32x16_bf16 v[64:79], v[108:111], v[116:119], v[64:79]
    s_waitcnt lgkmcnt(0)
    s_waitcnt vmcnt(2)
    ds_read_b64_tr_b16 v[108:109], v42 offset:5120
    ds_read_b64_tr_b16 v[110:111], v42 offset:5376
    ds_read_b128 v[116:119], v43 offset:416
    v_mfma_f32_32x32x16_bf16 v[64:79], v[96:99], v[104:107], v[64:79]
    s_waitcnt lgkmcnt(0)
    s_waitcnt vmcnt(1)
    ds_read_b64_tr_b16 v[96:97], v42 offset:6144
    ds_read_b64_tr_b16 v[98:99], v42 offset:6400
    ds_read_b128 v[104:107], v43 offset:448
    v_mfma_f32_32x32x16_bf16 v[64:79], v[108:111], v[116:119], v[64:79]
    s_waitcnt lgkmcnt(0)
    s_waitcnt vmcnt(0)
    ds_read_b64_tr_b16 v[108:109], v42 offset:7168
    ds_read_b64_tr_b16 v[110:111], v42 offset:7424
    ds_read_b128 v[116:119], v43 offset:480
    v_mfma_f32_32x32x16_bf16 v[64:79], v[96:99], v[104:107], v[64:79]
    s_waitcnt lgkmcnt(0)
    v_mfma_f32_32x32x16_bf16 v[64:79], v[108:111], v[116:119], v[64:79]
    s_nop 7
    s_nop 7
    v_and_b32 v6, 31, v2
    v_add_u32 v6, s29, v6
    v_lshlrev_b32 v6, 9, v6
    v_lshrrev_b32 v5, 5, v2
    v_lshl_add_u32 v6, v5, 3, v6
    v_add_u32 v6, s32, v6
    v_cvt_pk_bf16_f32 v8, v64, v65
    v_cvt_pk_bf16_f32 v9, v66, v67
    buffer_store_dwordx2 v[8:9], v6, s[24:27], 0 offen offset:0
    v_cvt_pk_bf16_f32 v10, v68, v69
    v_cvt_pk_bf16_f32 v11, v70, v71
    buffer_store_dwordx2 v[10:11], v6, s[24:27], 0 offen offset:16
    v_cvt_pk_bf16_f32 v12, v72, v73
    v_cvt_pk_bf16_f32 v13, v74, v75
    buffer_store_dwordx2 v[12:13], v6, s[24:27], 0 offen offset:32
    v_cvt_pk_bf16_f32 v14, v76, v77
    v_cvt_pk_bf16_f32 v15, v78, v79
    buffer_store_dwordx2 v[14:15], v6, s[24:27], 0 offen offset:48
L_done:
    s_endpgm
.section .rodata,"a"
.p2align 6
.amdhsa_kernel standalone__autoregressive_conv_wavenet__speech_kernel
  .amdhsa_next_free_vgpr 120
  .amdhsa_next_free_sgpr 48
  .amdhsa_accum_offset 120
  .amdhsa_group_segment_fixed_size 0
  .amdhsa_kernarg_size 48
  .amdhsa_user_sgpr_count 2
  .amdhsa_user_sgpr_kernarg_segment_ptr 1
  .amdhsa_system_sgpr_workgroup_id_x 1
.end_amdhsa_kernel
```
